```python
import torch

def _softmax(x, axis=-1):
    return torch.softmax(x, dim=axis)
def _gelu(x):
    return torch.nn.functional.gelu(x, approximate="tanh")
def _silu(x):
    return torch.nn.functional.silu(x)
def _sigmoid(x):
    return torch.sigmoid(x)
def _layernorm(x, axis=-1, eps=1e-5):
    m = x.mean(dim=axis, keepdim=True)
    v = x.var(dim=axis, keepdim=True, unbiased=False)
    return (x - m) / torch.sqrt(v + eps)
def _scatter_add(tgt, idx, src, axis=0):
    return tgt.clone().index_add_(axis, idx, src)
def _segment_sum(src, seg, n):
    out = torch.zeros((n,) + src.shape[1:], dtype=src.dtype)
    return out.index_add_(0, seg, src)
def _pad(x, pw):
    flat = tuple(v for pair in reversed(pw) for v in pair)
    return torch.nn.functional.pad(x, flat)

kernel_name = 'standalone__swiglu_ffn__decode'

def setup_inputs():

    _w = (lambda a: (lambda t: t.to(torch.bfloat16) if t.is_floating_point() else t)(torch.as_tensor(a)))
    B, S, D, F = 1, 1, 1024, 3584
    return {
        "x": _w((lambda *s: torch.randn(*s, dtype=torch.bfloat16) * 0.05)(B, S, D)),
        "w_gate": _w((lambda *s: torch.randn(*s, dtype=torch.bfloat16) * 0.05)(D, F)),
        "w_up": _w((lambda *s: torch.randn(*s, dtype=torch.bfloat16) * 0.05)(D, F)),
        "w_down": _w((lambda *s: torch.randn(*s, dtype=torch.bfloat16) * 0.05)(F, D)),
    }

def reference(x, w_gate, w_up, w_down):
    g = _silu(x @ w_gate)
    u = x @ w_up
    return (g * u) @ w_down
```

```asm
; @launch grid=(256,1,1) block=(512,1,1) lds=4096
.amdgcn_target "amdgcn-amd-amdhsa--gfx950"
.text
.globl standalone__swiglu_ffn__decode_kernel
.p2align 12
.p2align 8
.type standalone__swiglu_ffn__decode_kernel,@function
standalone__swiglu_ffn__decode_kernel:
  s_load_dwordx8 s[36:43], s[0:1], 0
  s_load_dwordx2 s[16:17], s[0:1], 48
  v_readfirstlane_b32 s3, v0
  s_mov_b32 s6, 7340032
  s_mov_b32 s7, 0x20000
  s_cmpk_ge_u32 s2, 224
  s_cbranch_scc1 L_help
  s_cmpk_ge_u32 s3, 256
  s_cbranch_scc1 L_q
  v_bfe_u32 v2, v0, 3, 3
  v_and_b32 v3, 7, v0
  v_mul_u32_u24 v1, 448, v2
  v_add_lshl_u32 v1, v1, v3, 4
  s_and_b32 s30, s2, 2
  s_lshl4_add_u32 s44, s30, s3
  s_mul_i32 s48, s44, 28672
  s_lshr_b32 s31, s2, 3
  s_xnor_b32 s31, s31, s2
  s_and_b32 s31, s31, 4
  s_and_b32 s30, s2, -8
  s_add_u32 s31, s31, s30
  s_lshl_b32 s31, s31, 5
  s_add_u32 s48, s48, s31
  s_mov_b32 s49, 57344
  s_cmpk_ge_u32 s3, 128
  s_cbranch_scc1 L_late
  s_bitcmp0_b32 s2, 0
  s_waitcnt lgkmcnt(0)
  s_cselect_b64 s[4:5], s[38:39], s[40:41]
L_pgo:
  buffer_load_dwordx4 v[16:19], v1, s[4:7], s48 offen nt
  s_add_u32 s48, s48, s49
  buffer_load_dwordx4 v[20:23], v1, s[4:7], s48 offen nt
  s_add_u32 s48, s48, s49
  v_and_b32 v4, 6, v2
  v_add_u32 v4, v4, v2
  v_lshl_add_u32 v4, v3, 4, v4
  s_lshl_b32 s30, s44, 2
  v_add_lshl_u32 v4, v4, s30, 1
  global_load_ushort v118, v4, s[36:37]
  global_load_ushort v119, v4, s[36:37] offset:4
  buffer_load_dwordx4 v[24:27], v1, s[4:7], s48 offen nt
  s_add_u32 s48, s48, s49
  buffer_load_dwordx4 v[28:31], v1, s[4:7], s48 offen nt
  s_add_u32 s48, s48, s49
  buffer_load_dwordx4 v[32:35], v1, s[4:7], s48 offen nt
  s_add_u32 s48, s48, s49
  buffer_load_dwordx4 v[36:39], v1, s[4:7], s48 offen nt
  s_add_u32 s48, s48, s49
  buffer_load_dwordx4 v[40:43], v1, s[4:7], s48 offen nt
  s_add_u32 s48, s48, s49
  buffer_load_dwordx4 v[44:47], v1, s[4:7], s48 offen nt
  s_add_u32 s48, s48, s49
  buffer_load_dwordx4 v[48:51], v1, s[4:7], s48 offen nt
  s_add_u32 s48, s48, s49
  buffer_load_dwordx4 v[52:55], v1, s[4:7], s48 offen nt
  s_add_u32 s48, s48, s49
  buffer_load_dwordx4 v[56:59], v1, s[4:7], s48 offen nt
  s_add_u32 s48, s48, s49
  buffer_load_dwordx4 v[60:63], v1, s[4:7], s48 offen nt
  s_add_u32 s48, s48, s49
  buffer_load_dwordx4 v[64:67], v1, s[4:7], s48 offen nt
  s_add_u32 s48, s48, s49
  buffer_load_dwordx4 v[68:71], v1, s[4:7], s48 offen nt
  s_add_u32 s48, s48, s49
  buffer_load_dwordx4 v[72:75], v1, s[4:7], s48 offen nt
  s_add_u32 s48, s48, s49
  buffer_load_dwordx4 v[76:79], v1, s[4:7], s48 offen nt
  s_cmpk_ge_u32 s3, 192
  s_cbranch_scc1 L_issued3
  s_load_dwordx2 s[22:23], s[16:17], 0
  s_barrier
  s_cmpk_ge_u32 s3, 128
  s_cbranch_scc1 L_prep
  s_barrier
L_prep:
  v_bfe_i32 v7, v0, 2, 1
  v_and_b32 v113, 0xffff, v7
  v_xor_b32 v112, 0xffff, v113
  v_lshlrev_b32 v114, 16, v112
  v_lshlrev_b32 v115, 16, v113
  v_and_b32 v120, 3, v0
  v_mul_u32_u24 v120, 0x5555, v120
  s_mov_b32 s34, 0x00ff00ff
  s_mov_b32 s35, s34
  s_and_b32 s45, s2, -16
  s_add_u32 s45, s45, s2
  s_lshl_b32 s45, s45, 9
  s_add_u32 s45, s45, 16384
  s_add_u32 s46, s45, 8192
  v_and_b32 v13, 63, v0
  v_lshlrev_b32 v117, 3, v13
  s_waitcnt vmcnt(14)
  v_lshl_or_b32 v6, v119, 16, v118
  ds_swizzle_b32 v8, v6 offset:0x18
  ds_swizzle_b32 v9, v6 offset:0x38
  ds_swizzle_b32 v10, v6 offset:0x58
  ds_swizzle_b32 v11, v6 offset:0x78
  ds_swizzle_b32 v12, v6 offset:0x98
  ds_swizzle_b32 v13, v6 offset:0xb8
  ds_swizzle_b32 v14, v6 offset:0xd8
  ds_swizzle_b32 v15, v6 offset:0xf8
  s_waitcnt lgkmcnt(0)
  s_add_u32 s22, s22, 0x7f4a7c15
  s_addc_u32 s23, s23, 0x9e3779b9
  v_and_b32 v80, v8, v112
  v_and_b32 v81, v8, v113
  v_and_b32 v82, v8, v114
  v_and_b32 v83, v8, v115
  v_and_b32 v84, v9, v112
  v_and_b32 v85, v9, v113
  v_and_b32 v86, v9, v114
  v_and_b32 v87, v9, v115
  v_and_b32 v88, v10, v112
  v_and_b32 v89, v10, v113
  v_and_b32 v90, v10, v114
  v_and_b32 v91, v10, v115
  v_and_b32 v92, v11, v112
  v_and_b32 v93, v11, v113
  v_and_b32 v94, v11, v114
  v_and_b32 v95, v11, v115
  v_and_b32 v96, v12, v112
  v_and_b32 v97, v12, v113
  v_and_b32 v98, v12, v114
  v_and_b32 v99, v12, v115
  v_and_b32 v100, v13, v112
  v_and_b32 v101, v13, v113
  v_and_b32 v102, v13, v114
  v_and_b32 v103, v13, v115
  v_and_b32 v104, v14, v112
  v_and_b32 v105, v14, v113
  v_and_b32 v106, v14, v114
  v_and_b32 v107, v14, v115
  v_and_b32 v108, v15, v112
  v_and_b32 v109, v15, v113
  v_and_b32 v110, v15, v114
  v_and_b32 v111, v15, v115
  v_mov_b64 v[8:9], 0
  v_mov_b64 v[10:11], 0
  v_mov_b32 v14, s22
  v_mov_b32 v15, s23
  v_mov_b32 v6, 0
  v_mov_b32 v7, 1
  s_cmpk_ge_u32 s3, 192
  s_cbranch_scc0 L_mm
  s_barrier
  s_branch L_pgo
L_late:
  s_bitcmp0_b32 s2, 0
  s_waitcnt lgkmcnt(0)
  s_cselect_b64 s[4:5], s[38:39], s[40:41]
  s_cmpk_ge_u32 s3, 192
  s_cbranch_scc1 L_late3
  s_barrier
  s_branch L_pgo
L_late3:
  v_and_b32 v4, 6, v2
  v_add_u32 v4, v4, v2
  v_lshl_add_u32 v4, v3, 4, v4
  s_lshl_b32 s30, s44, 2
  v_add_lshl_u32 v4, v4, s30, 1
  global_load_ushort v118, v4, s[36:37]
  global_load_ushort v119, v4, s[36:37] offset:4
  s_load_dwordx2 s[22:23], s[16:17], 0
  s_barrier
  s_waitcnt vmcnt(0)
  s_branch L_prep
L_help:
  s_cmpk_ge_u32 s2, 256
  s_cbranch_scc1 L_end
  s_cmpk_ge_u32 s3, 448
  s_cbranch_scc1 L_race
  s_bfe_u32 s29, s2, 0x30002
  s_and_b32 s31, s2, 2
  s_lshl_b32 s31, s31, 6
  s_cmp_ge_u32 s29, 7
  s_cbranch_scc1 L_free
  s_cmpk_ge_u32 s3, 320
  s_cbranch_scc1 L_end
  s_lshl_b32 s30, s29, 10
  s_addk_i32 s30, 0x180
  v_add_u32 v2, 192, v0
  v_and_b32 v1, 0x180, v2
  v_add3_u32 v1, v1, v2, s31
  v_mul_u32_u24 v1, 7168, v1
L_hgo:
  s_bitcmp0_b32 s2, 0
  s_waitcnt lgkmcnt(0)
  s_cselect_b64 s[4:5], s[38:39], s[40:41]
  buffer_load_dword v8, v1, s[4:7], s30 offen
L_end:
  s_endpgm
L_free:
  s_cmpk_ge_u32 s3, 448
  s_cbranch_scc1 L_end
  s_addk_i32 s31, 880
  v_and_b32 v1, 15, v0
  v_add_u32 v1, s31, v1
  v_mul_u32_u24 v1, 7168, v1
  v_lshrrev_b32 v2, 4, v0
  v_lshl_add_u32 v1, v2, 8, v1
  s_and_b32 s30, s3, 64
  s_lshl_b32 s30, s30, 1
  s_branch L_hgo
L_issued3:
  ds_write_b32 v6, v7 offset:1540
L_mm:
  s_mov_b32 s18, 704512
  s_mov_b32 s19, 0x20000
  v_bfe_u32 v5, v0, 4, 2
  v_and_b32 v116, 3, v0
  v_lshl_add_u32 v116, v5, 2, v116
  v_and_b32 v4, 4, v0
  v_lshl_add_u32 v116, v4, 2, v116
  v_lshlrev_b32 v116, 4, v116
  s_waitcnt vmcnt(16)
  v_smfmac_f32_16x16x64_bf16 v[8:11], v[80:83], v[16:23], v120
  s_waitcnt vmcnt(12)
  v_smfmac_f32_16x16x64_bf16 v[8:11], v[84:87], v[24:31], v120
  s_waitcnt vmcnt(10)
  v_smfmac_f32_16x16x64_bf16 v[8:11], v[88:91], v[32:39], v120
  s_waitcnt vmcnt(8)
  v_smfmac_f32_16x16x64_bf16 v[8:11], v[92:95], v[40:47], v120
  s_waitcnt vmcnt(6)
  v_smfmac_f32_16x16x64_bf16 v[8:11], v[96:99], v[48:55], v120
  s_waitcnt vmcnt(4)
  v_smfmac_f32_16x16x64_bf16 v[8:11], v[100:103], v[56:63], v120
  s_cbranch_scc0 L_nopick
L_pick:
  ds_read_b32 v7, v6 offset:1536
  ds_read2st64_b64 v[16:19], v117 offset0:0 offset1:1
  ds_read_b64 v[20:21], v117 offset:1024
  s_waitcnt lgkmcnt(0)
  v_cmp_ne_u32 vcc, 3, v7
  s_cbranch_vccnz L_pick
  v_pk_add_f32 v[16:17], v[16:17], v[18:19]
  v_pk_add_f32 v[16:17], v[16:17], v[20:21]
L_nopick:
  s_waitcnt vmcnt(2)
  v_smfmac_f32_16x16x64_bf16 v[8:11], v[104:107], v[64:71], v120
  s_cbranch_scc0 L_nob0
  s_barrier
L_nob0:
  s_waitcnt vmcnt(0)
  v_smfmac_f32_16x16x64_bf16 v[8:11], v[108:111], v[72:79], v120
  s_nop 7
  v_permlane32_swap_b32 v8, v9
  v_permlane32_swap_b32 v10, v11
  s_cbranch_scc0 L_plds
  v_add_f32_dpp v12, v9, v8 row_ror:8 row_mask:0xf bank_mask:0xf
  v_add_f32_dpp v13, v11, v10 row_ror:8 row_mask:0xf bank_mask:0xf
  s_mov_b64 exec, s[34:35]
  v_pk_add_f32 v[12:13], v[12:13], v[16:17]
  buffer_store_dwordx4 v[12:15], v116, s[16:19], s45 offen sc1
  buffer_store_dwordx4 v[12:15], v116, s[16:19], s46 offen sc1
  s_barrier
  s_endpgm
L_plds:
  v_add_f32_dpp v12, v9, v8 row_ror:8 row_mask:0xf bank_mask:0xf
  v_add_f32_dpp v13, v11, v10 row_ror:8 row_mask:0xf bank_mask:0xf
  v_lshlrev_b32 v1, 3, v0
  ds_write_b64 v1, v[12:13]
  s_mov_b64 exec, 1
  ds_add_u32 v6, v7 offset:1536
  s_mov_b64 exec, -1
  s_lshr_b32 s26, s3, 6
  s_mulk_i32 s26, 28
  s_lshr_b32 s29, s2, 3
  s_add_u32 s26, s26, s29
  s_cmp_ge_u32 s26, 32
  s_cbranch_scc1 L_pend
  s_load_dwordx2 s[24:25], s[0:1], 32
  s_and_b32 s28, s2, 7
  s_lshl_b32 s30, s28, 5
  s_add_u32 s27, s30, s26
  s_mulk_i32 s27, 896
  s_add_u32 s27, s27, 245760
  s_mul_i32 s45, s28, 896
  s_add_u32 s45, s45, s26
  s_lshl_b32 s45, s45, 5
  s_add_u32 s45, s45, 475136
  s_and_b32 s31, s26, 7
  s_lshl2_add_u32 s30, s31, s30
  s_lshr_b32 s31, s26, 3
  s_lshl1_add_u32 s30, s30, s31
  s_lshl_b32 s30, s30, 2
  v_and_b32 v2, 1, v5
  v_lshl_add_u32 v2, v2, 1, s30
  v_lshrrev_b32 v8, 1, v5
  v_lshl_add_u32 v2, v8, 4, v2
  v_and_b32 v4, 31, v0
  v_lshl_add_u32 v9, v4, 6, v8
  v_lshlrev_b32 v9, 4, v9
  v_lshl_add_u32 v4, v4, 1, v8
  v_lshlrev_b32 v4, 4, v4
  v_mov_b64 v[60:61], 0
  s_mov_b32 s34, 0x00010001
  s_mov_b32 s35, s34
  s_mov_b32 exec_lo, 0x0fffffff
  s_mov_b32 exec_hi, exec_lo
  s_mov_b32 s31, 0
  s_waitcnt lgkmcnt(0)
  s_barrier
  s_barrier
  buffer_load_dwordx4 v[16:19], v4, s[16:19], s27 offen sc1
  s_lshl_b32 s30, s28, 9
  s_addk_i32 s30, 4096
  v_and_b32 v10, 31, v0
  v_lshlrev_b32 v10, 4, v10
  buffer_load_dwordx2 v[20:21], v10, s[16:19], s30 offen sc1
  s_waitcnt vmcnt(0)
  v_cmp_eq_u64 vcc, s[22:23], v[20:21]
  s_bcnt1_i32_b32 s30, vcc_lo
  s_cmp_lt_u32 s30, 14
  s_cselect_b32 s31, 12, 0
  s_barrier
  s_barrier
  buffer_load_dwordx4 v[16:19], v4, s[16:19], s27 offen sc1
  buffer_load_dwordx4 v[20:23], v4, s[16:19], s27 offen sc1
  buffer_load_dwordx4 v[24:27], v4, s[16:19], s27 offen sc1
  buffer_load_dwordx4 v[28:31], v4, s[16:19], s27 offen sc1
L_poll:
  s_waitcnt vmcnt(3)
  v_cmp_ne_u64 vcc, s[22:23], v[16:17]
  v_mov_b64 v[60:61], v[18:19]
  s_and_b64 exec, exec, vcc
  s_cbranch_scc0 L_done
  buffer_load_dwordx4 v[16:19], v4, s[16:19], s27 offen sc1
  s_waitcnt vmcnt(3)
  v_cmp_ne_u64 vcc, s[22:23], v[20:21]
  v_mov_b64 v[60:61], v[22:23]
  s_and_b64 exec, exec, vcc
  s_cbranch_scc0 L_done
  buffer_load_dwordx4 v[20:23], v4, s[16:19], s27 offen sc1
  s_waitcnt vmcnt(3)
  v_cmp_ne_u64 vcc, s[22:23], v[24:25]
  v_mov_b64 v[60:61], v[26:27]
  s_and_b64 exec, exec, vcc
  s_cbranch_scc0 L_done
  buffer_load_dwordx4 v[24:27], v4, s[16:19], s27 offen sc1
  s_waitcnt vmcnt(3)
  v_cmp_ne_u64 vcc, s[22:23], v[28:29]
  v_mov_b64 v[60:61], v[30:31]
  s_and_b64 exec, exec, vcc
  s_cbranch_scc0 L_done
  buffer_load_dwordx4 v[28:31], v4, s[16:19], s27 offen sc1
  s_add_u32 s31, s31, 1
  s_cmp_lt_u32 s31, 12
  s_cbranch_scc1 L_poll
  s_mov_b32 s30, s45
  s_mov_b32 s45, s27
  s_mov_b32 s27, s30
  v_swap_b32 v4, v9
  s_bitcmp0_b32 s31, 22
  s_cbranch_scc1 L_poll
L_done:
  s_mov_b64 exec, -1
  v_permlane16_swap_b32 v60, v61
  v_add_f32 v60, v60, v61
  s_nop 1
  v_add_f32_dpp v60, v60, v60 row_ror:8 row_mask:0xf bank_mask:0xf
  s_nop 1
  v_add_f32_dpp v60, v60, v60 row_ror:4 row_mask:0xf bank_mask:0xf
  s_nop 1
  v_add_f32_dpp v60, v60, v60 row_ror:2 row_mask:0xf bank_mask:0xf
  s_nop 1
  v_add_f32_dpp v60, v60, v60 row_ror:1 row_mask:0xf bank_mask:0xf
  v_cvt_pk_bf16_f32 v60, v60, v60
  s_mov_b64 exec, s[34:35]
  global_store_short v2, v60, s[24:25]
  s_or_b32 s30, s2, s3
  s_cbranch_scc1 L_pend
  s_mov_b64 exec, 1
  buffer_store_dwordx2 v[14:15], off, s[16:19], 0
L_pend:
  s_endpgm
L_q:
  v_mov_b32 v6, 0
  v_mov_b32 v7, 0
  ds_write_b64 v6, v[6:7] offset:1536
  s_barrier
  s_mov_b32 s18, 704512
  s_mov_b32 s19, 0x20000
  s_and_b32 s28, s2, 7
  s_lshr_b32 s29, s2, 3
  s_sub_u32 s26, s3, 256
  v_and_b32 v4, 15, v0
  v_bfe_u32 v9, v0, 4, 1
  v_bfe_u32 v2, v0, 5, 1
  v_lshlrev_b32 v1, 4, v4
  v_lshl_add_u32 v1, v9, 13, v1
  v_lshl_add_u32 v1, v2, 11, v1
  s_lshl_b32 s30, s29, 8
  s_add_u32 s30, s30, s26
  s_lshl2_add_u32 s30, s30, s28
  s_lshl_b32 s48, s30, 8
  s_waitcnt lgkmcnt(0)
  s_load_dwordx2 s[22:23], s[16:17], 0
  v_lshrrev_b32 v3, 3, v4
  v_lshl_add_u32 v2, v2, 1, v3
  v_lshl_add_u32 v2, v2, 2, v9
  v_and_b32 v8, 1, v0
  v_lshl_add_u32 v2, v2, 1, v8
  v_bfe_u32 v3, v0, 1, 2
  v_lshl_add_u32 v2, v2, 2, v3
  v_lshlrev_b32 v2, 4, v2
  s_lshl_b32 s30, s2, 2
  s_xnor_b32 s30, s30, s26
  s_and_b32 s30, s30, 128
  s_and_b32 s31, s26, 64
  s_lshl2_add_u32 s30, s30, s31
  s_and_b32 s31, s29, -2
  s_add_u32 s31, s31, s29
  s_lshl_b32 s31, s31, 10
  s_add_u32 s30, s30, s31
  s_lshl_b32 s44, s30, 2
  s_add_u32 s44, s44, 16384
  v_bfe_u32 v7, v0, 2, 1
  v_lshl_add_u32 v7, v7, 1, v8
  v_mul_u32_u24 v60, 0x5555, v7
  v_bfe_u32 v3, v0, 1, 5
  v_mul_u32_u24 v3, 896, v3
  v_lshl_add_u32 v3, v8, 4, v3
  v_and_b32 v53, 63, v0
  v_min_u32 v53, 27, v53
  v_lshlrev_b32 v53, 4, v53
  v_lshlrev_b32 v52, 3, v0
  s_getreg_b32 s27, hwreg(HW_REG_XCC_ID)
  v_mov_b64 v[8:9], 0
  v_mov_b64 v[10:11], 0
  v_mov_b64 v[64:65], 0
  v_mov_b64 v[66:67], 0
  v_mov_b64 v[68:69], 0
  v_mov_b64 v[70:71], 0
  v_mov_b64 v[72:73], 0
  v_mov_b64 v[74:75], 0
  v_mov_b64 v[76:77], 0
  v_mov_b64 v[78:79], 0
  s_mul_i32 s46, s28, 28672
  s_lshl_b32 s31, s29, 4
  s_lshl1_add_u32 s46, s31, s46
  s_add_u32 s46, s46, 245760
  s_lshl_b32 s47, s28, 9
  s_addk_i32 s47, 4096
  s_add_u32 s30, s47, s31
  v_mov_b32 v56, s27
  s_mov_b64 s[4:5], s[42:43]
  s_waitcnt lgkmcnt(0)
  s_add_u32 s22, s22, 0x7f4a7c15
  s_addc_u32 s23, s23, 0x9e3779b9
  s_barrier
  s_cmp_lg_u32 s26, 0
  s_cbranch_scc1 L_qa
  v_mov_b32 v54, s22
  v_mov_b32 v55, s23
  s_mov_b64 exec, 1
  buffer_store_dwordx3 v[54:56], off, s[16:19], s30
  s_mov_b64 exec, -1
L_qa:
  ds_read_b32 v7, v6 offset:1540
  s_waitcnt lgkmcnt(0)
  v_cmp_eq_u32 vcc, 0, v7
  s_cbranch_vccnz L_qa
  s_mov_b32 s31, 0
  buffer_load_dwordx4 v[16:19], v1, s[4:7], s48 offen nt
  s_addk_i32 s48, 4096
  buffer_load_dwordx4 v[20:23], v1, s[4:7], s48 offen nt
  s_addk_i32 s48, 12288
  buffer_load_dwordx4 v[24:27], v1, s[4:7], s48 offen nt
  s_addk_i32 s48, 4096
  buffer_load_dwordx4 v[28:31], v1, s[4:7], s48 offen nt
  s_addk_i32 s48, 12288
  s_barrier
  buffer_load_dwordx4 v[32:35], v1, s[4:7], s48 offen nt
  s_addk_i32 s48, 4096
  s_barrier
  buffer_load_dwordx4 v[36:39], v1, s[4:7], s48 offen nt
  s_addk_i32 s48, 12288
  buffer_load_dwordx4 v[40:43], v1, s[4:7], s48 offen nt
  s_addk_i32 s48, 4096
  buffer_load_dwordx4 v[44:47], v1, s[4:7], s48 offen nt
  s_waitcnt vmcnt(5)
  s_add_u32 s30, s47, 448
  s_load_dwordx16 s[52:67], s[16:17], s30
  s_bfe_i32 s32, s2, 0x10004
  s_waitcnt lgkmcnt(0)
  s_cmp_eq_u64 s[52:53], s[22:23]
  s_cselect_b32 s33, s54, 0
  s_add_u32 s32, s32, s33
  s_cmp_eq_u64 s[56:57], s[22:23]
  s_cselect_b32 s33, s58, 0
  s_add_u32 s32, s32, s33
  s_cmp_eq_u64 s[60:61], s[22:23]
  s_cselect_b32 s33, s62, 0
  s_add_u32 s32, s32, s33
  s_cmp_eq_u64 s[64:65], s[22:23]
  s_cselect_b32 s33, s66, 0
  s_add_u32 s32, s32, s33
  s_lshr_b32 s30, s32, 18
  s_and_b32 s30, s30, 8192
  s_add_u32 s44, s44, s30
  s_cmp_lg_u32 s26, 0
  s_waitcnt vmcnt(3)
  s_cbranch_scc1 L_gather
  buffer_load_dwordx3 v[12:14], v53, s[16:19], s47 offen sc1
L_gather:
  buffer_load_dwordx4 v[48:51], v2, s[16:19], s44 offen sc1
  s_add_u32 s31, s31, 1
  s_bitcmp1_b32 s31, 22
  s_cbranch_scc1 L_gok
  s_waitcnt vmcnt(0)
  v_cmp_ne_u64 vcc, s[22:23], v[50:51]
  v_permlane32_swap_b32 v48, v49
  v_add_f32 v48, v48, v49
  s_cbranch_vccnz L_gather
L_gok:
  v_cvt_pk_bf16_f32 v48, 0, v48
  v_mul_f32 v49, 0xbfb8aa3b, v48
  v_exp_f32 v49, v49
  v_mov_b32_dpp v50, v48 row_ror:8 row_mask:0xf bank_mask:0xf
  v_add_f32 v49, 1.0, v49
  v_rcp_f32 v49, v49
  s_cmp_lg_u32 s26, 0
  v_mul_f32 v49, v48, v49
  v_cvt_pk_bf16_f32 v49, 0, v49
  v_mul_f32 v49, v50, v49
  v_cvt_pk_bf16_f32 v49, v49, 0
  s_nop 1
  v_mov_b32_dpp v64, v49 row_newbcast:0 row_mask:0xf bank_mask:0x3
  v_mov_b32_dpp v65, v49 row_newbcast:0 row_mask:0xf bank_mask:0xc
  v_mov_b32_dpp v66, v49 row_newbcast:1 row_mask:0xf bank_mask:0x3
  v_mov_b32_dpp v67, v49 row_newbcast:1 row_mask:0xf bank_mask:0xc
  v_mov_b32_dpp v68, v49 row_newbcast:2 row_mask:0xf bank_mask:0x3
  v_mov_b32_dpp v69, v49 row_newbcast:2 row_mask:0xf bank_mask:0xc
  v_smfmac_f32_16x16x64_bf16 v[8:11], v[64:67], v[16:23], v60
  v_mov_b32_dpp v70, v49 row_newbcast:3 row_mask:0xf bank_mask:0x3
  v_mov_b32_dpp v71, v49 row_newbcast:3 row_mask:0xf bank_mask:0xc
  v_mov_b32_dpp v72, v49 row_newbcast:4 row_mask:0xf bank_mask:0x3
  v_mov_b32_dpp v73, v49 row_newbcast:4 row_mask:0xf bank_mask:0xc
  v_smfmac_f32_16x16x64_bf16 v[8:11], v[68:71], v[24:31], v60
  v_mov_b32_dpp v74, v49 row_newbcast:5 row_mask:0xf bank_mask:0x3
  v_mov_b32_dpp v75, v49 row_newbcast:5 row_mask:0xf bank_mask:0xc
  v_mov_b32_dpp v76, v49 row_newbcast:6 row_mask:0xf bank_mask:0x3
  v_mov_b32_dpp v77, v49 row_newbcast:6 row_mask:0xf bank_mask:0xc
  v_smfmac_f32_16x16x64_bf16 v[8:11], v[72:75], v[32:39], v60
  v_mov_b32_dpp v78, v49 row_newbcast:7 row_mask:0xf bank_mask:0x3
  v_mov_b32_dpp v79, v49 row_newbcast:7 row_mask:0xf bank_mask:0xc
  s_nop 1
  v_smfmac_f32_16x16x64_bf16 v[8:11], v[76:79], v[40:47], v60
  s_cbranch_scc0 L_q0
  s_nop 6
  ds_write_b64 v52, v[8:9]
  s_waitcnt lgkmcnt(0)
  s_barrier
L_qend:
  s_endpgm
L_q0:
  v_cmp_ne_u64 vcc, s[22:23], v[12:13]
  v_cmp_ne_u32 s[60:61], s27, v14
  s_or_b32 s30, vcc_lo, s60
  s_bcnt1_i32_b32 s50, s30
  s_cmp_gt_u32 s50, 14
  s_cselect_b32 s46, s18, s46
  s_barrier
  ds_read_b64 v[16:17], v52 offset:512
  ds_read2st64_b64 v[20:23], v52 offset0:2 offset1:3
  s_waitcnt lgkmcnt(1)
  v_pk_add_f32 v[8:9], v[8:9], v[16:17]
  s_waitcnt lgkmcnt(0)
  v_pk_add_f32 v[20:21], v[20:21], v[22:23]
  v_pk_add_f32 v[56:57], v[8:9], v[20:21]
  buffer_store_dwordx4 v[54:57], v3, s[16:19], s46 offen
  s_barrier
  s_cmp_eq_u32 s50, 0
  s_cbranch_scc1 L_qend
  s_mul_i32 s46, s28, 28
  s_add_u32 s46, s46, s29
  s_lshl_b32 s46, s46, 10
  s_add_u32 s46, s46, 471040
  v_lshlrev_b32 v3, 1, v52
  buffer_store_dwordx4 v[54:57], v3, s[16:19], s46 offen sc1
  s_endpgm
L_race:
  s_and_b32 s30, s2, 31
  s_lshl_b32 s30, s30, 7
  s_bitcmp1_b32 s2, 3
  s_cselect_b32 s24, 8192, 0
  s_cselect_b32 s27, 1, -1
  s_add_u32 s24, s24, s30
  s_xor_b32 s25, s24, 8192
  s_waitcnt lgkmcnt(0)
  s_add_u32 s20, s16, s24
  s_addc_u32 s21, s17, 0
  s_add_u32 s32, s16, s25
  s_addc_u32 s33, s17, 0
  s_load_dword s31, s[20:21], 0xac000
  s_load_dword s31, s[20:21], 0xb0000
  s_load_dword s31, s[32:33], 0xac000
  s_load_dword s31, s[32:33], 0xb0000
  s_waitcnt lgkmcnt(2)
  s_and_b32 s28, s2, 7
  s_bfe_u32 s29, s2, 0x20003
  s_lshl_b32 s28, s28, 9
  s_lshl4_add_u32 s28, s29, s28
  s_xor_b32 s20, s20, 128
  s_xor_b32 s32, s32, 128
  s_getreg_b32 s26, hwreg(HW_REG_IB_STS, 8, 4)
  s_waitcnt lgkmcnt(0)
  s_load_dword s31, s[20:21], 0xac000
  s_load_dword s31, s[20:21], 0xb0000
  s_load_dword s31, s[32:33], 0xac000
  s_load_dword s31, s[32:33], 0xb0000
  s_waitcnt lgkmcnt(2)
  s_addk_i32 s28, 4544
  s_mov_b32 s18, 704512
  s_mov_b32 s19, 0x20000
  s_sub_u32 s26, 2, s26
  s_mov_b64 exec, 1
  s_getreg_b32 s29, hwreg(HW_REG_IB_STS, 8, 4)
  s_load_dwordx2 s[22:23], s[16:17], 0
  s_load_dword s31, s[16:17], s28
  s_sub_u32 s26, s26, s29
  s_mul_i32 s26, s26, s27
  s_waitcnt lgkmcnt(0)
  s_add_u32 s22, s22, 0x7f4a7c15
  s_addc_u32 s23, s23, 0x9e3779b9
  v_mov_b32 v2, s22
  v_mov_b32 v3, s23
  v_mov_b32 v4, s26
  buffer_store_dwordx3 v[2:4], off, s[16:19], s28
  s_endpgm
.section .rodata,"a"
.p2align 6
.amdhsa_kernel standalone__swiglu_ffn__decode_kernel
  .amdhsa_next_free_vgpr 152
  .amdhsa_next_free_sgpr 72
  .amdhsa_accum_offset 152
  .amdhsa_group_segment_fixed_size 0
  .amdhsa_kernarg_size 56
  .amdhsa_user_sgpr_count 2
  .amdhsa_user_sgpr_kernarg_segment_ptr 1
  .amdhsa_system_sgpr_workgroup_id_x 1
  .amdhsa_float_denorm_mode_32 3
.end_amdhsa_kernel
```
